```python
import torch

def _softmax(x, axis=-1):
    return torch.softmax(x, dim=axis)
def _gelu(x):
    return torch.nn.functional.gelu(x, approximate="tanh")
def _silu(x):
    return torch.nn.functional.silu(x)
def _sigmoid(x):
    return torch.sigmoid(x)
def _layernorm(x, axis=-1, eps=1e-5):
    m = x.mean(dim=axis, keepdim=True)
    v = x.var(dim=axis, keepdim=True, unbiased=False)
    return (x - m) / torch.sqrt(v + eps)
def _scatter_add(tgt, idx, src, axis=0):
    return tgt.clone().index_add_(axis, idx, src)
def _segment_sum(src, seg, n):
    out = torch.zeros((n,) + src.shape[1:], dtype=src.dtype)
    return out.index_add_(0, seg, src)
def _pad(x, pw):
    flat = tuple(v for pair in reversed(pw) for v in pair)
    return torch.nn.functional.pad(x, flat)

kernel_name = 'sequential_preLN__sliding_block_cached__geglu_ffn__decode'

def setup_inputs():

    _w = (lambda a: (lambda t: t.to(torch.bfloat16) if t.is_floating_point() else t)(torch.as_tensor(a)))
    def _A_setup():
        B, Sq, D = 1, 1, 1024
        Hq, Hkv, Sk, Dh = 32, 4, 65536, 128
        assert Hq % Hkv == 0, (Hq, Hkv)
        return {
            "x": _w((lambda *s: torch.randn(*s, dtype=torch.bfloat16) * 0.05)(B, Sq, D)),
            "k_cache": _w((lambda *s: torch.randn(*s, dtype=torch.bfloat16) * 3.2)(B, Hkv, Sk, Dh)),
            "v_cache": _w((lambda *s: torch.randn(*s, dtype=torch.bfloat16) * 0.4)(B, Hkv, Sk, Dh)),
            "wq": _w((lambda *s: torch.randn(*s, dtype=torch.bfloat16) * 3.2)(D, Hq * Dh) * (D ** -0.5)),
            "wo": _w((lambda *s: torch.randn(*s, dtype=torch.bfloat16) * 0.4)(Hq * Dh, D) * ((Hq * Dh) ** -0.5)),
        }
    _A_in = _A_setup()

    def _B_setup():
        B, S, D, F = 1, 1, 1024, 3584
        return {
            "x": _w((lambda *s: torch.randn(*s, dtype=torch.bfloat16) * 0.05)(B, S, D)),
            "w_gate": _w((lambda *s: torch.randn(*s, dtype=torch.bfloat16) * 0.05)(D, F)),
            "w_up": _w((lambda *s: torch.randn(*s, dtype=torch.bfloat16) * 0.05)(D, F)),
            "w_down": _w((lambda *s: torch.randn(*s, dtype=torch.bfloat16) * 0.05)(F, D)),
        }
    _B_in = _B_setup()

    return {
        "A_x": _A_in["x"],
        "A_k_cache": _A_in["k_cache"],
        "A_v_cache": _A_in["v_cache"],
        "A_wq": _A_in["wq"],
        "A_wo": _A_in["wo"],
        "B_x": _B_in["x"],
        "B_w_gate": _B_in["w_gate"],
        "B_w_up": _B_in["w_up"],
        "B_w_down": _B_in["w_down"],
    }

def reference(A_x, A_k_cache, A_v_cache, A_wq, A_wo, B_x, B_w_gate, B_w_up, B_w_down):
    def _A_ref(x, k_cache, v_cache, wq, wo):
        B, Sq, D = x.shape
        Hq, Dh = 32, 128
        Hkv, Sk = k_cache.shape[1], k_cache.shape[2]
        W = min(4096, max(256, Sk // 4))
        rep = Hq // Hkv
        q = (lambda x, *d: x.permute(*d))((x @ wq).reshape(B, Sq, Hq, Dh), 0, 2, 1, 3)
        k = (lambda x, n, axis: torch.repeat_interleave(x, n, dim=axis))(k_cache[:, :, Sk - W:, :], rep, axis=1)
        v = (lambda x, n, axis: torch.repeat_interleave(x, n, dim=axis))(v_cache[:, :, Sk - W:, :], rep, axis=1)
        scores = torch.einsum("bhqd,bhkd->bhqk", q, k) * (Dh ** -0.5)
        p = _softmax(scores, axis=-1)
        o = torch.einsum("bhqk,bhkd->bhqd", p, v)
        return (lambda x, *d: x.permute(*d))(o, 0, 2, 1, 3).reshape(B, Sq, Hq * Dh) @ wo

    def _B_ref(x, w_gate, w_up, w_down):
        return (_gelu(x @ w_gate) * (x @ w_up)) @ w_down

    x = A_x
    h = x + _A_ref(_layernorm(x, axis=-1), A_k_cache, A_v_cache, A_wq, A_wo)
    h2 = h + _B_ref(_layernorm(h, axis=-1), B_w_gate, B_w_up, B_w_down)
    return h2
```

```asm
; @launch grid=(256,1,1) block=(512,1,1) lds=98304
.amdgcn_target "amdgcn-amd-amdhsa--gfx950"
.text
.globl sequential_preLN__sliding_block_cached__geglu_ffn__decode_kernel
.p2align 8
.type sequential_preLN__sliding_block_cached__geglu_ffn__decode_kernel,@function
sequential_preLN__sliding_block_cached__geglu_ffn__decode_kernel:
    s_cmp_ge_u32 s2, 0x100
    s_cbranch_scc1 L_end
    s_load_dwordx2 s[4:5], s[0:1], 88
    s_load_dwordx2 s[16:17], s[0:1], 0
    s_and_b32 s29, s2, 7
    s_bfe_u32 s30, s2, 0x40003
    v_lshrrev_b32 v1, 4, v0
    v_and_b32 v2, 15, v0
    v_lshrrev_b32 v4, 6, v0
    s_mov_b32 s18, 2048
    s_mov_b32 s19, 0x20000
    s_bitcmp1_b32 s2, 7
    s_cbranch_scc1 L_Q
    s_load_dwordx2 s[8:9], s[0:1], 24
    s_load_dwordx2 s[12:13], s[0:1], 32
    s_load_dwordx2 s[20:21], s[0:1], 64
    v_readfirstlane_b32 s31, v4
    v_and_b32 v3, 7, v0
    v_lshlrev_b32 v3, 4, v3
    v_bfe_u32 v5, v0, 3, 1
    v_lshl_or_b32 v3, v5, 8, v3
    v_lshl_or_b32 v3, v1, 13, v3
    s_mov_b32 s10, 0x800000
    s_mov_b32 s11, 0x20000
    s_lshr_b32 s40, s30, 2
    s_lshl_b32 s41, s40, 21
    s_and_b32 s42, s30, 2
    s_lshl2_add_u32 s42, s29, s42
    s_lshl_b32 s43, s42, 8
    s_add_u32 s41, s41, s43
    s_and_b32 s43, s30, 1
    s_lshl_b32 s43, s43, 7
    s_add_u32 s41, s41, s43
    s_lshl_b32 s43, s40, 9
    v_and_b32 v6, 63, v0
    v_lshlrev_b32 v4, 4, v6
    v_and_b32 v5, 7, v0
    v_lshl_add_u32 v5, v5, 5, v1
    v_lshlrev_b32 v5, 1, v5
    s_waitcnt lgkmcnt(0)
    buffer_load_dwordx4 v[8:11], v4, s[16:19], 0 offen
    buffer_load_dwordx4 v[12:15], v4, s[16:19], 0 offen offset:1024
    buffer_load_ushort v16, v5, s[16:19], s43 offen
    v_mov_b32 v113, v3
    buffer_load_dwordx4 v[32:35], v113, s[8:11], s41 offen nt
    s_add_u32 s41, s41, 0x40000
    buffer_load_dwordx4 v[36:39], v113, s[8:11], s41 offen nt
    s_add_u32 s41, s41, 0x40000
    buffer_load_dwordx4 v[40:43], v113, s[8:11], s41 offen nt
    s_add_u32 s41, s41, 0x40000
    buffer_load_dwordx4 v[44:47], v113, s[8:11], s41 offen nt
    s_add_u32 s41, s41, 0x40000
    buffer_load_dwordx4 v[48:51], v113, s[8:11], s41 offen nt
    s_add_u32 s41, s41, 0x40000
    buffer_load_dwordx4 v[52:55], v113, s[8:11], s41 offen nt
    s_add_u32 s41, s41, 0x40000
    buffer_load_dwordx4 v[56:59], v113, s[8:11], s41 offen nt
    s_add_u32 s41, s41, 0x40000
    buffer_load_dwordx4 v[60:63], v113, s[8:11], s41 offen nt
    s_load_dword s28, s[4:5], 0
    s_branch L_P1
L_Q:
    s_load_dwordx2 s[8:9], s[0:1], 8
    s_load_dwordx2 s[12:13], s[0:1], 16
    s_load_dwordx4 s[20:23], s[0:1], 48
    v_readfirstlane_b32 s31, v4
    s_getpc_b64 s[40:41]
L_pc:
    v_lshlrev_b32 v5, 7, v0
    v_min_u32 v5, L_last-L_pc-4, v5
    s_cmp_gt_u32 s31, 1
    s_cbranch_scc1 L_nopf
    global_load_dword v126, v5, s[40:41]
L_nopf:
    s_mov_b32 s10, 0x4000000
    s_mov_b32 s11, 0x20000
    s_mov_b32 s14, 0x4000000
    s_mov_b32 s15, 0x20000
    v_bfe_u32 v3, v0, 4, 2
    v_and_b32 v6, 63, v0
    v_xor_b32 v7, v2, v3
    v_lshlrev_b32 v7, 4, v7
    v_lshl_or_b32 v8, v3, 8, v7
    v_lshlrev_b32 v7, 1, v3
    v_xor_b32 v7, v2, v7
    v_lshlrev_b32 v7, 4, v7
    v_lshl_or_b32 v12, v3, 8, v7
    v_xor_b32 v13, 0x80, v12
    v_xor_b32 v9, 64, v8
    v_xor_b32 v10, 128, v8
    v_xor_b32 v11, 192, v8
    s_lshr_b32 s42, s29, 1
    s_and_b32 s43, s29, 1
    s_lshl4_add_u32 s43, s43, s30
    s_lshl_b32 s44, s42, 24
    s_lshl_b32 s45, s43, 15
    s_add_u32 s44, s44, s45
    s_lshl_b32 s45, s31, 12
    s_add_u32 s44, s44, s45
    s_add_u32 s44, s44, 15728640
    s_waitcnt lgkmcnt(0)
    s_load_dword s28, s[4:5], 0
    s_bitcmp1_b32 s30, 0
    s_cselect_b64 s[24:25], s[20:21], s[22:23]
    s_cselect_b64 s[20:21], s[22:23], s[20:21]
    s_mov_b32 s6, 4194304
    s_mov_b32 s7, 0x20000
    s_mov_b32 m0, s45
    s_waitcnt lgkmcnt(0)
    buffer_load_dwordx4 v8, s[8:11], s44 offen offset:0 nt lds
    s_add_u32 s28, s28, 0x9e3779b1
    s_mov_b32 s33, 0x07060501
    s_mov_b32 s34, 0x07060502
    s_mov_b32 s35, 0x07060503
    s_mov_b32 s36, 0x0c04000c
    s_mov_b32 s37, 0x04020100
    s_mov_b32 s38, 0x3f803f80
    s_mov_b32 s32, 100000
    v_and_b32 v14, 31, v0
    v_bfe_u32 v15, v0, 5, 1
    v_lshlrev_b32 v16, 3, v14
    v_lshl_add_u32 v16, v15, 2, v16
    s_lshl_b32 s46, s31, 8
    v_and_b32 v14, 3, v0
    v_lshlrev_b32 v14, 6, v14
    v_lshl_add_u32 v14, v15, 1, v14
    v_bfe_u32 v17, v0, 4, 1
    v_lshl_add_u32 v14, v17, 2, v14
    s_lshl_b32 s47, s29, 8
    s_lshl3_add_u32 s47, s31, s47
    v_add_u32 v110, s47, v14
    buffer_load_ushort v100, v110, s[16:19], 0 offen
    v_mov_b32 v127, 0x7ff00000
    v_mov_b32 v123, s28
    v_mov_b32 v119, s28
    s_getreg_b32 s47, hwreg(HW_REG_XCC_ID, 0, 4)
    s_lshl4_add_u32 s48, s29, s30
    s_lshl_b32 s48, s48, 7
    s_add_u32 s48, s48, 32768
    v_mov_b32 v118, s47
    v_mov_b32 v109, s48
    v_cmp_eq_u32 vcc, 0, v0
    s_nop 1
    v_cndmask_b32 v109, v127, v109, vcc
L_noxcc:
    s_and_b32 s47, s30, 1
    s_lshl3_add_u32 s47, s47, s31
    s_lshl4_add_u32 s47, s29, s47
    s_lshl4_add_u32 s48, s29, s30
    s_lshl3_add_u32 s48, s48, s31
    s_lshl_b32 s48, s48, 2
    s_add_u32 s48, s48, 16384
    v_mov_b32 v117, s48
    v_cmp_eq_u32 vcc, 0, v6
    s_nop 1
    v_cndmask_b32 v117, v127, v117, vcc
    s_mul_i32 s47, s31, 272
    s_add_u32 s47, s47, 65536
    v_add_u32 v101, s47, v16
    s_add_u32 s46, s46, 0
    v_add_u32 v102, s46, v16
    s_lshl3_add_u32 s47, s42, s31
    s_lshl_b32 s47, s47, 11
    s_add_u32 s47, s47, 65536
    v_lshlrev_b32 v17, 4, v6
    v_add_u32 v103, s47, v17
    v_add_u32 v104, 67840, v17
    s_lshr_b32 s47, s31, 1
    s_lshl_b32 s47, s47, 10
    s_and_b32 s48, s31, 1
    s_lshl3_add_u32 s47, s48, s47
    v_add_u32 v105, s47, v104
    v_and_b32 v18, 7, v0
    v_mul_u32_u24 v19, 272, v18
    v_lshl_add_u32 v19, v3, 4, v19
    v_add_u32 v106, 65536, v19
    v_lshlrev_b32 v107, 2, v2
    v_add_u32 v107, 67712, v107
    v_mov_b32 v19, 0xff800000
    ds_write_b32 v107, v19
    v_xor_b32 v19, v2, v3
    v_lshlrev_b32 v19, 4, v19
    v_lshl_or_b32 v19, v2, 8, v19
    s_lshl_b32 s47, s31, 12
    v_add_u32 v20, s47, v19
    v_xor_b32 v21, 64, v20
    v_xor_b32 v22, 128, v20
    v_xor_b32 v23, 192, v20
    v_lshrrev_b32 v19, 2, v2
    v_lshl_add_u32 v19, v3, 2, v19
    v_and_b32 v24, 7, v19
    v_lshlrev_b32 v24, 1, v24
    v_bfe_u32 v25, v0, 1, 1
    v_lshl_add_u32 v25, s31, 1, v25
    v_xor_b32 v24, v24, v25
    v_lshlrev_b32 v24, 4, v24
    v_lshl_or_b32 v24, v19, 8, v24
    v_and_b32 v25, 1, v0
    v_lshl_or_b32 v24, v25, 3, v24
    s_lshl_b32 s47, s42, 17
    s_lshr_b32 s48, s31, 1
    s_lshl_b32 s48, s48, 12
    s_add_u32 s47, s47, s48
    s_lshl_b32 s48, s43, 7
    s_add_u32 s47, s47, s48
    s_and_b32 s48, s31, 1
    s_lshl_b32 s48, s48, 6
    s_add_u32 s47, s47, s48
    s_add_u32 s47, s47, 2097152
    v_and_b32 v19, 7, v0
    v_lshlrev_b32 v19, 14, v19
    v_lshl_add_u32 v19, v3, 4, v19
    v_bfe_u32 v25, v0, 3, 1
    v_lshl_add_u32 v19, v25, 19, v19
    v_add_u32 v116, s47, v19
    v_mov_b32 v112, s38
    v_mov_b32 v113, s38
    v_mov_b32 v114, s38
    v_mov_b32 v115, s38
    s_mov_b32 s52, 0x3db504f3
    s_mov_b32 s53, 0x3db504f3
    s_mov_b32 s54, 0x3fb8aa3b
    s_mov_b32 s55, 0x3fb8aa3b
    s_mov_b32 s22, 7340032
    s_mov_b32 s23, 0x20000
    s_mov_b32 s26, 7340032
    s_mov_b32 s27, 0x20000
    s_mul_i32 s40, s29, 14
    s_add_u32 s40, s40, s30
    s_mov_b32 s41, s30
    s_mov_b32 s40, s29
    s_mul_i32 s58, s40, 917504
    v_mul_u32_u24 v4, 7168, v1
    s_lshr_b32 s59, s41, 1
    s_mul_i32 s59, s59, 896
    s_add_u32 s60, s59, 512
    s_add_u32 s59, s58, s59
    s_add_u32 s58, s58, s60
    v_lshl_add_u32 v111, v2, 4, v4
    v_mov_b32 v102, v111
    v_cmp_gt_u32 vcc, 8, v2
    s_nop 1
    v_cndmask_b32 v102, v127, v102, vcc
    v_bfe_u32 v5, v0, 5, 1
    v_bfe_u32 v7, v0, 4, 1
    s_lshl_b32 s46, s40, 14
    s_and_b32 s46, s46, 0xc000
    s_lshr_b32 s47, s40, 2
    s_mul_i32 s47, s47, 131072
    s_add_u32 s46, s46, s47
    s_and_b32 s47, s31, 1
    s_lshl_b32 s48, s47, 10
    s_add_u32 s46, s46, s48
    s_xor_b32 s47, s47, s41
    s_and_b32 s47, s47, 1
    s_lshl_b32 s47, s47, 16
    s_add_u32 s46, s46, s47
    s_lshr_b32 s47, s41, 1
    s_mul_i32 s47, s47, 1792
    s_add_u32 s46, s46, s47
    s_and_b32 s47, s31, 2
    s_lshl_b32 s47, s47, 8
    v_lshl_add_u32 v7, v2, 1, v7
    v_lshlrev_b32 v7, 4, v7
    v_lshl_add_u32 v7, v5, 18, v7
    s_add_u32 s46, s46, s47
    s_add_u32 s46, s46, 1310720
    v_add_u32 v124, s46, v7
    s_cmp_eq_u32 s30, 15
    s_cselect_b32 s57, 4, 0
    s_xor_b32 s57, s57, s31
    s_cmp_eq_u32 s57, 3
    s_cselect_b32 s47, 8, 16
    v_cmp_gt_u32 vcc, s47, v2
    s_nop 1
    v_cndmask_b32 v124, v127, v124, vcc
    s_waitcnt vmcnt(0)
    buffer_load_dwordx4 v9, s[8:11], s44 offen offset:1024 nt lds
    buffer_load_dwordx4 v10, s[8:11], s44 offen offset:2048 nt lds
    buffer_load_dwordx4 v11, s[8:11], s44 offen offset:3072 nt lds
    s_add_u32 s45, s45, 32768
    s_mov_b32 m0, s45
    s_nop 0
    buffer_load_dwordx4 v12, s[12:15], s44 offen offset:0 nt lds
    buffer_load_dwordx4 v13, s[12:15], s44 offen offset:1024 nt lds
    buffer_load_dwordx4 v12, s[12:15], s44 offen offset:2048 nt lds
    buffer_load_dwordx4 v13, s[12:15], s44 offen offset:3072 nt lds
    s_waitcnt vmcnt(0)
    ds_read_b128 v[32:35], v20 offset:0
    ds_read_b128 v[36:39], v21 offset:0
    ds_read_b128 v[40:43], v22 offset:0
    ds_read_b128 v[44:47], v23 offset:0
    s_waitcnt lgkmcnt(0)
    s_barrier
    ds_read_b64_tr_b16 v[48:49], v24 offset:32768
    ds_read_b64_tr_b16 v[50:51], v24 offset:36864
    ds_read_b64_tr_b16 v[52:53], v24 offset:40960
    ds_read_b64_tr_b16 v[54:55], v24 offset:45056
    ds_read_b64_tr_b16 v[56:57], v24 offset:49152
    ds_read_b64_tr_b16 v[58:59], v24 offset:53248
    ds_read_b64_tr_b16 v[60:61], v24 offset:57344
    ds_read_b64_tr_b16 v[62:63], v24 offset:61440
    s_mov_b32 s56, 0
L_gq:
    buffer_load_dwordx4 v[8:11], v103, s[4:7], s56 offen sc1
    buffer_load_dwordx4 v[12:15], v103, s[4:7], s56 offen offset:1024 sc1
L_gq_w:
    s_waitcnt vmcnt(0)
L_gq_c:
    v_cmp_ne_u32 vcc, s28, v11
    v_cmp_ne_u32 s[50:51], s28, v15
    s_or_b64 vcc, vcc, s[50:51]
    s_cbranch_scc1 L_gq_r
    v_perm_b32 v16, v9, v8, s36
    v_perm_b32 v11, v10, v16, s37
    v_perm_b32 v17, v13, v12, s36
    v_perm_b32 v15, v14, v17, s37
    v_pk_add_f32 v[8:9], v[8:9], v[12:13]
    v_pk_add_f32 v[10:11], v[10:11], v[14:15]
    s_nop 1
    v_permlane32_swap_b32 v8, v10
    v_permlane32_swap_b32 v9, v11
    v_pk_add_f32 v[8:9], v[8:9], v[10:11]
    v_cvt_pk_bf16_f32 v8, v8, v9
    ds_write_b32 v101, v8
    buffer_load_dwordx4 v[128:131], v111, s[20:23], s59 offen offset:0 nt
    s_waitcnt lgkmcnt(0)
    s_barrier
    ds_read_b128 v[64:67], v106 offset:0
    ds_read_b128 v[68:71], v106 offset:64
    ds_read_b128 v[72:75], v106 offset:128
    ds_read_b128 v[76:79], v106 offset:192
    buffer_load_dwordx4 v[132:135], v111, s[24:27], s58 offen offset:0 nt
    s_waitcnt lgkmcnt(3)
    v_mfma_f32_16x16x32_bf16 v[8:11], v[32:35], v[64:67], 0
    s_waitcnt lgkmcnt(2)
    v_mfma_f32_16x16x32_bf16 v[8:11], v[36:39], v[68:71], v[8:11]
    s_waitcnt lgkmcnt(1)
    v_mfma_f32_16x16x32_bf16 v[8:11], v[40:43], v[72:75], v[8:11]
    s_waitcnt lgkmcnt(0)
    v_mfma_f32_16x16x32_bf16 v[8:11], v[44:47], v[76:79], v[8:11]
    s_nop 7
    v_cvt_pk_bf16_f32 v8, 0, v8
    v_cvt_pk_bf16_f32 v9, 0, v9
    v_cvt_pk_bf16_f32 v10, 0, v10
    v_cvt_pk_bf16_f32 v11, 0, v11
    v_pk_mul_f32 v[8:9], v[8:9], s[52:53]
    v_pk_mul_f32 v[10:11], v[10:11], s[52:53]
    v_cvt_pk_bf16_f32 v8, 0, v8
    v_cvt_pk_bf16_f32 v9, 0, v9
    v_cvt_pk_bf16_f32 v10, 0, v10
    v_cvt_pk_bf16_f32 v11, 0, v11
    v_max3_f32 v12, v8, v9, v10
    v_max_f32 v12, v12, v11
    ds_max_f32 v107, v12
    buffer_store_dwordx2 v[118:119], v109, s[4:7], 0 offen sc1
    s_waitcnt lgkmcnt(0)
    s_barrier
    ds_read_b32 v14, v107
    buffer_load_dwordx4 v[136:139], v111, s[20:23], s59 offen offset:256 nt
    s_add_u32 s59, s59, 229376
    s_waitcnt lgkmcnt(0)
    v_mul_f32 v14, s54, v14
    v_pk_fma_f32 v[8:9], v[8:9], s[54:55], v[14:15] op_sel_hi:[1,1,0] neg_lo:[0,0,1] neg_hi:[0,0,1]
    v_pk_fma_f32 v[10:11], v[10:11], s[54:55], v[14:15] op_sel_hi:[1,1,0] neg_lo:[0,0,1] neg_hi:[0,0,1]
    v_exp_f32 v8, v8
    v_exp_f32 v9, v9
    v_exp_f32 v10, v10
    v_exp_f32 v11, v11
    v_cvt_pk_bf16_f32 v8, v8, v9
    v_cvt_pk_bf16_f32 v9, v10, v11
    ds_write_b64 v105, v[8:9]
    buffer_load_dwordx4 v[140:143], v102, s[24:27], s58 offen offset:256 nt
    s_add_u32 s58, s58, 229376
    s_waitcnt lgkmcnt(0)
    s_barrier
    ds_read_b128 v[64:67], v104 offset:0
    ds_read_b128 v[68:71], v104 offset:1024
    ds_read_b128 v[72:75], v104 offset:2048
    ds_read_b128 v[76:79], v104 offset:3072
    s_waitcnt lgkmcnt(3)
    v_mfma_f32_16x16x32_bf16 v[16:19], v[112:115], v[64:67], 0
    v_mfma_f32_16x16x32_bf16 v[8:11], v[48:51], v[64:67], 0
    s_waitcnt lgkmcnt(2)
    v_mfma_f32_16x16x32_bf16 v[16:19], v[112:115], v[68:71], v[16:19]
    v_mfma_f32_16x16x32_bf16 v[8:11], v[52:55], v[68:71], v[8:11]
    s_waitcnt lgkmcnt(1)
    v_mfma_f32_16x16x32_bf16 v[16:19], v[112:115], v[72:75], v[16:19]
    v_mfma_f32_16x16x32_bf16 v[8:11], v[56:59], v[72:75], v[8:11]
    s_waitcnt lgkmcnt(0)
    v_mfma_f32_16x16x32_bf16 v[16:19], v[112:115], v[76:79], v[16:19]
    v_mfma_f32_16x16x32_bf16 v[8:11], v[60:63], v[76:79], v[8:11]
    s_nop 6
    v_rcp_f32 v20, v16
    v_log_f32 v122, v16
    v_pk_mul_f32 v[8:9], v[8:9], v[20:21] op_sel_hi:[1,0]
    v_pk_mul_f32 v[10:11], v[10:11], v[20:21] op_sel_hi:[1,0]
    v_add_f32 v122, v122, v14
    v_cvt_pk_bf16_f32 v120, v8, v9
    v_cvt_pk_bf16_f32 v121, v10, v11
    buffer_store_dwordx4 v[120:123], v116, s[4:7], 0 offen sc1
    buffer_store_dword v123, v117, s[4:7], 0 offen
    s_barrier
    buffer_load_dwordx4 v[144:147], v111, s[20:23], s59 offen offset:0 nt
    buffer_load_dwordx4 v[148:151], v111, s[24:27], s58 offen offset:0 nt
    buffer_load_dwordx4 v[152:155], v111, s[20:23], s59 offen offset:256 nt
    s_add_u32 s59, s59, 229376
    buffer_load_dwordx4 v[156:159], v102, s[24:27], s58 offen offset:256 nt
    s_add_u32 s58, s58, 229376
    buffer_load_dwordx4 v[160:163], v111, s[20:23], s59 offen offset:0 nt
    buffer_load_dwordx4 v[164:167], v111, s[24:27], s58 offen offset:0 nt
    buffer_load_dwordx4 v[168:171], v111, s[20:23], s59 offen offset:256 nt
    s_add_u32 s59, s59, 229376
    buffer_load_dwordx4 v[172:175], v102, s[24:27], s58 offen offset:256 nt
    s_add_u32 s58, s58, 229376
    v_mov_b32 v5, 0xffff
    v_lshrrev_b32 v4, 2, v0
    v_xor_b32 v4, v4, v0
    v_and_b32 v4, 8, v4
    v_cmp_eq_u32 vcc, 0, v4
    s_nop 1
    v_cndmask_b32 v5, 0, v5, vcc
    v_and_b32 v4, 4, v0
    v_cmp_eq_u32 vcc, 0, v4
    s_nop 1
    v_cndmask_b32 v24, 0, v5, vcc
    v_cndmask_b32 v25, v5, 0, vcc
    v_and_b32 v4, 3, v0
    v_xor_b32 v5, 1, v4
    v_lshl_or_b32 v4, v5, 2, v4
    v_mul_u32_u24 v26, 0x1111, v4
    v_mov_b32 v96, 0
    v_mov_b32 v97, 0
    v_mov_b32 v98, 0
    v_mov_b32 v99, 0
    v_mov_b32 v112, 0
    v_mov_b32 v113, 0
    v_mov_b32 v114, 0
    v_mov_b32 v115, 0
    v_mov_b32 v88, 0
    v_mov_b32 v89, 0
    v_mov_b32 v90, 0
    v_mov_b32 v91, 0
    v_mov_b32 v92, 0
    v_mov_b32 v93, 0
    v_mov_b32 v94, 0
    v_mov_b32 v95, 0
    v_and_b32 v28, 0x3f80, v24
    v_and_b32 v29, 0x3f80, v25
    v_mov_b32 v30, v28
    v_mov_b32 v31, v29
    v_and_b32 v4, 3, v0
    v_lshlrev_b32 v4, 4, v4
    v_lshrrev_b32 v5, 2, v6
    v_lshl_add_u32 v4, v5, 9, v4
    s_lshl_b32 s42, s29, 13
    s_lshl_b32 s43, s31, 6
    s_add_u32 s42, s42, s43
    s_add_u32 s42, s42, 1048576
    v_add_u32 v103, s42, v4
    v_lshlrev_b32 v107, 4, v6
    s_lshl_b32 s42, s31, 10
    v_add_u32 v107, s42, v107
    v_and_b32 v4, 31, v0
    v_lshlrev_b32 v4, 4, v4
    v_bfe_u32 v5, v0, 5, 1
    v_lshl_add_u32 v4, v5, 14, v4
    s_and_b32 s42, s31, 2
    s_lshl_b32 s42, s42, 12
    s_and_b32 s43, s31, 1
    s_lshl_b32 s43, s43, 9
    s_add_u32 s42, s42, s43
    v_add_u32 v106, s42, v4
    s_lshl_b32 s42, s29, 12
    s_add_u32 s42, s42, 3211264
    v_lshl_add_u32 v108, v6, 4, s42
    s_mov_b32 s56, 0
    s_load_dwordx2 s[8:9], s[0:1], 72
    s_mov_b32 s10, 2048
    v_add_u32 v105, 786432, v103
    v_and_b32 v4, 3, v0
    v_lshlrev_b32 v7, 4, v4
    v_lshrrev_b32 v5, 2, v6
    v_lshl_add_u32 v7, v5, 12, v7
    s_lshl3_add_u32 s42, s29, s31
    s_lshl_b32 s42, s42, 5
    s_add_u32 s42, s42, 3145728
    v_add_u32 v125, s42, v7
    v_cmp_gt_u32 vcc, 2, v4
    s_nop 1
    v_cndmask_b32 v125, v127, v125, vcc
    v_and_b32 v7, 12, v0
    v_cmp_eq_u32 vcc, 0, v7
    s_nop 1
    v_cndmask_b32 v110, v127, v110, vcc
    s_lshl_b32 s46, s29, 5
    s_add_u32 s46, s46, s30
    s_lshl_b32 s46, s46, 2
    s_add_u32 s46, s46, 12288
    v_mov_b32 v104, s46
    v_or_b32 v4, s57, v6
    v_cmp_eq_u32 vcc, 0, v4
    s_nop 1
    v_cndmask_b32 v104, v127, v104, vcc
    buffer_load_dwordx4 v[176:179], v111, s[20:23], s59 offen offset:0 nt
    buffer_load_dwordx4 v[180:183], v111, s[24:27], s58 offen offset:0 nt
    buffer_load_dwordx4 v[184:187], v111, s[20:23], s59 offen offset:256 nt
    buffer_load_dwordx4 v[188:191], v102, s[24:27], s58 offen offset:256 nt
    s_waitcnt vmcnt(2)
    buffer_load_dwordx4 v[8:11], v103, s[4:7], 0 offen sc1
    s_waitcnt vmcnt(1)
    v_lshlrev_b32 v100, 16, v100
    v_smfmac_f32_16x16x64_bf16 v[88:91], v[28:31], v[128:135], v26
    v_smfmac_f32_16x16x64_bf16 v[92:95], v[28:31], v[136:143], v26
    v_smfmac_f32_16x16x64_bf16 v[88:91], v[28:31], v[144:151], v26
    v_smfmac_f32_16x16x64_bf16 v[92:95], v[28:31], v[152:159], v26
    v_smfmac_f32_16x16x64_bf16 v[88:91], v[28:31], v[160:167], v26
    v_smfmac_f32_16x16x64_bf16 v[92:95], v[28:31], v[168:175], v26
    v_smfmac_f32_16x16x64_bf16 v[88:91], v[28:31], v[176:183], v26
    v_smfmac_f32_16x16x64_bf16 v[92:95], v[28:31], v[184:191], v26
    s_nop 6
    ds_write_b128 v107, v[88:91] offset:20480
    ds_write_b128 v107, v[92:95] offset:28672
L_gc_w:
    s_waitcnt vmcnt(0)
    v_cmp_ne_u32 vcc, s28, v11
    s_cbranch_vccnz L_gc_r
    v_perm_b32 v16, v9, v8, s36
    v_perm_b32 v11, v10, v16, s37
    v_permlane16_swap_b32 v8, v10
    s_nop 0
    v_permlane16_swap_b32 v9, v11
    v_pk_add_f32 v[8:9], v[8:9], v[10:11]
    s_nop 1
    v_permlane32_swap_b32 v8, v9
    v_add_f32 v8, v8, v9
    s_nop 1
    v_add_f32_dpp v8, v8, v8 row_ror:8 row_mask:0xf bank_mask:0xf
    s_nop 1
    v_add_f32_dpp v8, v8, v8 row_ror:4 row_mask:0xf bank_mask:0xf
    v_cvt_pk_bf16_f32 v8, 0, v8
    v_add_f32 v8, v8, v100
    v_cvt_pk_bf16_f32 v100, 0, v8
    v_cvt_pk_bf16_f32 v8, v8, v8
    v_mov_b32 v9, v8
    s_nop 1
    v_permlane32_swap_b32 v8, v9
    s_nop 1
    v_and_b32_dpp v12, v8, v24 row_newbcast:0 row_mask:0xf bank_mask:0xf
    v_and_b32_dpp v13, v8, v25 row_newbcast:0 row_mask:0xf bank_mask:0xf
    v_and_b32_dpp v14, v9, v24 row_newbcast:0 row_mask:0xf bank_mask:0xf
    v_and_b32_dpp v15, v9, v25 row_newbcast:0 row_mask:0xf bank_mask:0xf
    v_and_b32_dpp v16, v8, v24 row_newbcast:1 row_mask:0xf bank_mask:0xf
    v_and_b32_dpp v17, v8, v25 row_newbcast:1 row_mask:0xf bank_mask:0xf
    v_and_b32_dpp v18, v9, v24 row_newbcast:1 row_mask:0xf bank_mask:0xf
    v_and_b32_dpp v19, v9, v25 row_newbcast:1 row_mask:0xf bank_mask:0xf
    v_smfmac_f32_16x16x64_bf16 v[96:99], v[12:15], v[128:135], v26
    v_smfmac_f32_16x16x64_bf16 v[112:115], v[12:15], v[136:143], v26
    v_and_b32_dpp v12, v8, v24 row_newbcast:2 row_mask:0xf bank_mask:0xf
    v_and_b32_dpp v13, v8, v25 row_newbcast:2 row_mask:0xf bank_mask:0xf
    v_and_b32_dpp v14, v9, v24 row_newbcast:2 row_mask:0xf bank_mask:0xf
    v_and_b32_dpp v15, v9, v25 row_newbcast:2 row_mask:0xf bank_mask:0xf
    v_smfmac_f32_16x16x64_bf16 v[96:99], v[16:19], v[144:151], v26
    v_smfmac_f32_16x16x64_bf16 v[112:115], v[16:19], v[152:159], v26
    v_and_b32_dpp v16, v8, v24 row_newbcast:3 row_mask:0xf bank_mask:0xf
    v_and_b32_dpp v17, v8, v25 row_newbcast:3 row_mask:0xf bank_mask:0xf
    v_and_b32_dpp v18, v9, v24 row_newbcast:3 row_mask:0xf bank_mask:0xf
    v_and_b32_dpp v19, v9, v25 row_newbcast:3 row_mask:0xf bank_mask:0xf
    v_smfmac_f32_16x16x64_bf16 v[96:99], v[12:15], v[160:167], v26
    v_smfmac_f32_16x16x64_bf16 v[112:115], v[12:15], v[168:175], v26
    v_smfmac_f32_16x16x64_bf16 v[96:99], v[16:19], v[176:183], v26
    v_smfmac_f32_16x16x64_bf16 v[112:115], v[16:19], v[184:191], v26
    s_cmp_gt_u32 s57, 3
    s_cbranch_scc1 L_sa
    buffer_load_dwordx4 v[20:23], v108, s[4:7], s56 offen sc1
L_sa:
    s_cmp_ge_u32 s30, 14
    s_cbranch_scc1 L_hst
L_hst_x:
    s_nop 2
    ds_write_b128 v107, v[96:99] offset:4096
    ds_write_b128 v107, v[112:115] offset:12288
    s_waitcnt lgkmcnt(0)
    s_barrier
    s_cmp_gt_u32 s57, 3
    s_cbranch_scc1 L_q4
    ds_read_b128 v[32:35], v106 offset:4096
    ds_read_b128 v[36:39], v106 offset:5120
    ds_read_b128 v[40:43], v106 offset:6144
    ds_read_b128 v[44:47], v106 offset:7168
    ds_read_b128 v[48:51], v106 offset:8192
    ds_read_b128 v[52:55], v106 offset:9216
    ds_read_b128 v[56:59], v106 offset:10240
    ds_read_b128 v[60:63], v106 offset:11264
    s_waitcnt lgkmcnt(6)
    v_pk_add_f32 v[32:33], v[32:33], v[36:37]
    v_pk_add_f32 v[34:35], v[34:35], v[38:39]
    s_waitcnt lgkmcnt(4)
    v_pk_add_f32 v[40:41], v[40:41], v[44:45]
    v_pk_add_f32 v[42:43], v[42:43], v[46:47]
    s_waitcnt lgkmcnt(2)
    v_pk_add_f32 v[48:49], v[48:49], v[52:53]
    v_pk_add_f32 v[50:51], v[50:51], v[54:55]
    s_waitcnt lgkmcnt(0)
    v_pk_add_f32 v[56:57], v[56:57], v[60:61]
    v_pk_add_f32 v[58:59], v[58:59], v[62:63]
    v_pk_add_f32 v[32:33], v[32:33], v[40:41]
    v_pk_add_f32 v[34:35], v[34:35], v[42:43]
    v_pk_add_f32 v[48:49], v[48:49], v[56:57]
    v_pk_add_f32 v[50:51], v[50:51], v[58:59]
    v_pk_add_f32 v[32:33], v[32:33], v[48:49]
    v_pk_add_f32 v[34:35], v[34:35], v[50:51]
    v_mov_b32 v36, v32
    v_mov_b32 v37, v33
    v_mov_b32 v38, v34
    v_mov_b32 v39, v35
    v_permlane32_swap_b32 v32, v36
    v_permlane32_swap_b32 v33, v37
    v_permlane32_swap_b32 v34, v38
    v_permlane32_swap_b32 v35, v39
    s_waitcnt vmcnt(0)
L_gs_c:
    v_cmp_ne_u32 vcc, s28, v21
    v_cmp_ne_u32 s[50:51], s28, v23
    s_or_b64 vcc, vcc, s[50:51]
    s_cbranch_scc1 L_gs_r
    v_add_f32 v20, v20, v22
    s_nop 1
    v_add_f32_dpp v20, v20, v20 quad_perm:[1,0,3,2] row_mask:0xf bank_mask:0xf
    s_nop 1
    v_add_f32_dpp v20, v20, v20 quad_perm:[2,3,0,1] row_mask:0xf bank_mask:0xf
    s_nop 1
    v_add_f32_dpp v20, v20, v20 row_half_mirror row_mask:0xf bank_mask:0xf
    s_nop 1
    v_add_f32_dpp v20, v20, v20 row_mirror row_mask:0xf bank_mask:0xf
    v_mov_b32 v21, v20
    s_nop 1
    v_permlane16_swap_b32 v20, v21
    v_add_f32 v20, v20, v21
    v_mov_b32 v21, v20
    s_nop 1
    v_permlane32_swap_b32 v20, v21
    v_add_f32 v20, v20, v21
    v_mul_f32 v20, 0x3a800000, v20
    v_cvt_pk_bf16_f32 v20, 0, v20
    v_pk_fma_f32 v[32:33], v[36:37], v[20:21], v[32:33] op_sel_hi:[1,0,1] neg_lo:[1,0,0] neg_hi:[1,0,0]
    v_pk_fma_f32 v[34:35], v[38:39], v[20:21], v[34:35] op_sel_hi:[1,0,1] neg_lo:[1,0,0] neg_hi:[1,0,0]
    v_perm_b32 v120, v32, v35, s33
    v_perm_b32 v121, v33, v35, s34
    v_perm_b32 v122, v34, v35, s35
    buffer_store_dwordx4 v[120:123], v124, s[4:7], 0 offen sc1
    buffer_store_dword v123, v104, s[4:7], 0 offen
    s_endpgm
L_g3:
    buffer_load_dwordx4 v[8:11], v105, s[4:7], 0 offen sc1
    s_waitcnt vmcnt(0)
    v_cmp_ne_u32 vcc, s28, v11
    s_cbranch_vccnz L_g3_r
    v_perm_b32 v16, v9, v8, s36
    v_perm_b32 v11, v10, v16, s37
    v_permlane16_swap_b32 v8, v10
    s_nop 0
    v_permlane16_swap_b32 v9, v11
    v_pk_add_f32 v[8:9], v[8:9], v[10:11]
    s_nop 1
    v_permlane32_swap_b32 v8, v9
    v_add_f32 v8, v8, v9
    s_nop 1
    v_add_f32_dpp v8, v8, v8 row_ror:8 row_mask:0xf bank_mask:0xf
    s_nop 1
    v_add_f32_dpp v8, v8, v8 row_ror:4 row_mask:0xf bank_mask:0xf
    v_cvt_pk_bf16_f32 v8, 0, v8
    v_add_f32 v8, v8, v100
    v_cvt_pk_bf16_f32 v8, v8, v8
    s_waitcnt lgkmcnt(0)
    buffer_store_short v8, v110, s[8:11], 0 offen
L_hfin:
    s_endpgm
L_P1:
    s_mov_b32 s33, 0x07060501
    s_mov_b32 s34, 0x07060502
    s_mov_b32 s35, 0x07060503
    s_mov_b32 s36, 0x0c04000c
    s_mov_b32 s37, 0x04020100
    s_mov_b32 s38, 0x3f803f80
    s_mov_b32 s32, 100000
    s_mov_b32 s6, 4194304
    s_mov_b32 s7, 0x20000
    s_mov_b32 s14, 0x800000
    s_mov_b32 s15, 0x20000
    s_mov_b32 s22, 7340032
    s_mov_b32 s23, 0x20000
    v_and_b32 v4, 1, v0
    v_lshlrev_b32 v4, 4, v4
    v_mov_b32 v5, 0xffff
    v_lshlrev_b32 v5, v4, v5
    v_bfe_u32 v4, v0, 1, 2
    v_cmp_eq_u32 s[44:45], 0, v4
    v_cmp_eq_u32 s[46:47], 1, v4
    v_cmp_eq_u32 s[48:49], 2, v4
    v_cmp_eq_u32 s[50:51], 3, v4
    v_cndmask_b32 v24, 0, v5, s[44:45]
    v_cndmask_b32 v25, 0, v5, s[46:47]
    v_cndmask_b32 v26, 0, v5, s[48:49]
    v_cndmask_b32 v27, 0, v5, s[50:51]
    v_mov_b32 v127, 0x7ff00000
    v_bfe_u32 v3, v0, 4, 2
    v_and_b32 v4, 31, v0
    v_lshlrev_b32 v100, 4, v4
    s_lshl_b32 s44, s31, 9
    v_add_u32 v101, s44, v100
    v_and_b32 v5, 1, v3
    v_lshl_add_u32 v4, v2, 1, v5
    v_lshlrev_b32 v4, 4, v4
    s_lshl_b32 s44, s42, 11
    s_lshl_b32 s45, s40, 9
    s_add_u32 s44, s44, s45
    s_add_u32 s44, s44, 65536
    s_and_b32 s45, s30, 1
    s_lshl_b32 s45, s45, 8
    s_add_u32 s44, s44, s45
    v_and_b32 v7, 0xff, v4
    v_bfe_u32 v17, v0, 3, 1
    v_lshl_add_u32 v7, v17, 11, v7
    v_add_u32 v102, s44, v7
    s_lshl_b32 s44, s29, 13
    s_lshl_b32 s45, s30, 9
    s_add_u32 s44, s44, s45
    s_add_u32 s44, s44, 1835008
    v_and_b32 v4, 3, v0
    v_lshlrev_b32 v4, 7, v4
    v_lshl_add_u32 v4, v5, 6, v4
    v_bfe_u32 v17, v0, 2, 2
    v_lshl_add_u32 v4, v17, 4, v4
    v_add_u32 v103, s44, v4
    v_cmp_gt_u32 vcc, 32, v6
    v_add_u32 v7, 65536, v102
    s_nop 0
    v_cndmask_b32 v102, v7, v102, vcc
    v_cndmask_b32 v103, v127, v103, vcc
    s_waitcnt vmcnt(8)
    v_dot2_f32_bf16 v17, v8, s38, 0
    v_dot2_f32_bf16 v17, v9, s38, v17
    v_dot2_f32_bf16 v17, v10, s38, v17
    v_dot2_f32_bf16 v17, v11, s38, v17
    v_dot2_f32_bf16 v17, v12, s38, v17
    v_dot2_f32_bf16 v17, v13, s38, v17
    v_dot2_f32_bf16 v17, v14, s38, v17
    v_dot2_f32_bf16 v17, v15, s38, v17
    v_lshlrev_b32 v64, 16, v8
    v_and_b32 v65, 0xffff0000, v8
    v_lshlrev_b32 v66, 16, v9
    v_and_b32 v67, 0xffff0000, v9
    v_lshlrev_b32 v68, 16, v10
    v_and_b32 v69, 0xffff0000, v10
    v_lshlrev_b32 v70, 16, v11
    v_and_b32 v71, 0xffff0000, v11
    v_lshlrev_b32 v72, 16, v12
    v_and_b32 v73, 0xffff0000, v12
    v_lshlrev_b32 v74, 16, v13
    v_and_b32 v75, 0xffff0000, v13
    v_lshlrev_b32 v76, 16, v14
    v_and_b32 v77, 0xffff0000, v14
    v_lshlrev_b32 v78, 16, v15
    v_and_b32 v79, 0xffff0000, v15
    v_add_f32_dpp v17, v17, v17 quad_perm:[1,0,3,2] row_mask:0xf bank_mask:0xf
    s_nop 1
    v_add_f32_dpp v17, v17, v17 quad_perm:[2,3,0,1] row_mask:0xf bank_mask:0xf
    s_nop 1
    v_add_f32_dpp v17, v17, v17 row_half_mirror row_mask:0xf bank_mask:0xf
    s_nop 1
    v_add_f32_dpp v17, v17, v17 row_mirror row_mask:0xf bank_mask:0xf
    s_nop 1
    v_add_f32_dpp v17, v17, v17 row_bcast:15 row_mask:0xa bank_mask:0xf
    s_nop 1
    v_add_f32_dpp v17, v17, v17 row_bcast:31 row_mask:0xc bank_mask:0xf
    v_mul_f32 v17, 0x3a800000, v17
    s_nop 0
    v_readlane_b32 s46, v17, 63
    v_mul_f32 v107, 0x41000000, v17
    s_nop 0
    v_pk_add_f32 v[64:65], v[64:65], s[46:47] op_sel_hi:[1,0] neg_lo:[0,1] neg_hi:[0,1]
    v_pk_add_f32 v[66:67], v[66:67], s[46:47] op_sel_hi:[1,0] neg_lo:[0,1] neg_hi:[0,1]
    v_pk_add_f32 v[68:69], v[68:69], s[46:47] op_sel_hi:[1,0] neg_lo:[0,1] neg_hi:[0,1]
    v_pk_add_f32 v[70:71], v[70:71], s[46:47] op_sel_hi:[1,0] neg_lo:[0,1] neg_hi:[0,1]
    v_pk_add_f32 v[72:73], v[72:73], s[46:47] op_sel_hi:[1,0] neg_lo:[0,1] neg_hi:[0,1]
    v_pk_add_f32 v[74:75], v[74:75], s[46:47] op_sel_hi:[1,0] neg_lo:[0,1] neg_hi:[0,1]
    v_pk_add_f32 v[76:77], v[76:77], s[46:47] op_sel_hi:[1,0] neg_lo:[0,1] neg_hi:[0,1]
    v_pk_add_f32 v[78:79], v[78:79], s[46:47] op_sel_hi:[1,0] neg_lo:[0,1] neg_hi:[0,1]
    v_pk_mul_f32 v[18:19], v[64:65], v[64:65]
    v_pk_fma_f32 v[18:19], v[66:67], v[66:67], v[18:19]
    v_pk_fma_f32 v[18:19], v[68:69], v[68:69], v[18:19]
    v_pk_fma_f32 v[18:19], v[70:71], v[70:71], v[18:19]
    v_pk_fma_f32 v[18:19], v[72:73], v[72:73], v[18:19]
    v_pk_fma_f32 v[18:19], v[74:75], v[74:75], v[18:19]
    v_pk_fma_f32 v[18:19], v[76:77], v[76:77], v[18:19]
    v_pk_fma_f32 v[18:19], v[78:79], v[78:79], v[18:19]
    v_add_f32 v18, v18, v19
    v_cvt_pk_bf16_f32 v19, 0, s46
    v_lshlrev_b32 v16, 16, v16
    v_add_f32_dpp v18, v18, v18 quad_perm:[1,0,3,2] row_mask:0xf bank_mask:0xf
    s_nop 1
    v_add_f32_dpp v18, v18, v18 quad_perm:[2,3,0,1] row_mask:0xf bank_mask:0xf
    s_nop 1
    v_add_f32_dpp v18, v18, v18 row_half_mirror row_mask:0xf bank_mask:0xf
    s_nop 1
    v_add_f32_dpp v18, v18, v18 row_mirror row_mask:0xf bank_mask:0xf
    s_nop 1
    v_add_f32_dpp v18, v18, v18 row_bcast:15 row_mask:0xa bank_mask:0xf
    s_nop 1
    v_add_f32_dpp v18, v18, v18 row_bcast:31 row_mask:0xc bank_mask:0xf
    v_mul_f32 v18, 0x3a800000, v18
    v_sub_f32 v16, v16, v19
    v_readlane_b32 s47, v18, 63
    v_cvt_pk_bf16_f32 v16, 0, v16
    s_nop 0
    v_cvt_pk_bf16_f32 v18, 0, s47
    v_add_f32 v18, 0x3727c5ac, v18
    v_cvt_pk_bf16_f32 v18, 0, v18
    v_sqrt_f32 v18, v18
    s_nop 0
    v_cvt_pk_bf16_f32 v18, 0, v18
    v_rcp_f32 v18, v18
    s_nop 0
    v_mul_f32 v16, v16, v18
    v_cvt_pk_bf16_f32 v16, v16, v16
    s_nop 1
    v_and_b32_dpp v64, v16, v24 row_newbcast:0 row_mask:0xf bank_mask:0xf
    v_and_b32_dpp v65, v16, v25 row_newbcast:0 row_mask:0xf bank_mask:0xf
    v_and_b32_dpp v66, v16, v26 row_newbcast:0 row_mask:0xf bank_mask:0xf
    v_and_b32_dpp v67, v16, v27 row_newbcast:0 row_mask:0xf bank_mask:0xf
    v_and_b32_dpp v68, v16, v24 row_newbcast:1 row_mask:0xf bank_mask:0xf
    v_and_b32_dpp v69, v16, v25 row_newbcast:1 row_mask:0xf bank_mask:0xf
    v_and_b32_dpp v70, v16, v26 row_newbcast:1 row_mask:0xf bank_mask:0xf
    v_and_b32_dpp v71, v16, v27 row_newbcast:1 row_mask:0xf bank_mask:0xf
    v_and_b32_dpp v72, v16, v24 row_newbcast:2 row_mask:0xf bank_mask:0xf
    v_and_b32_dpp v73, v16, v25 row_newbcast:2 row_mask:0xf bank_mask:0xf
    v_and_b32_dpp v74, v16, v26 row_newbcast:2 row_mask:0xf bank_mask:0xf
    v_and_b32_dpp v75, v16, v27 row_newbcast:2 row_mask:0xf bank_mask:0xf
    v_and_b32_dpp v76, v16, v24 row_newbcast:3 row_mask:0xf bank_mask:0xf
    v_and_b32_dpp v77, v16, v25 row_newbcast:3 row_mask:0xf bank_mask:0xf
    v_and_b32_dpp v78, v16, v26 row_newbcast:3 row_mask:0xf bank_mask:0xf
    v_and_b32_dpp v79, v16, v27 row_newbcast:3 row_mask:0xf bank_mask:0xf
    v_and_b32_dpp v80, v16, v24 row_newbcast:4 row_mask:0xf bank_mask:0xf
    v_and_b32_dpp v81, v16, v25 row_newbcast:4 row_mask:0xf bank_mask:0xf
    v_and_b32_dpp v82, v16, v26 row_newbcast:4 row_mask:0xf bank_mask:0xf
    v_and_b32_dpp v83, v16, v27 row_newbcast:4 row_mask:0xf bank_mask:0xf
    v_and_b32_dpp v84, v16, v24 row_newbcast:5 row_mask:0xf bank_mask:0xf
    v_and_b32_dpp v85, v16, v25 row_newbcast:5 row_mask:0xf bank_mask:0xf
    v_and_b32_dpp v86, v16, v26 row_newbcast:5 row_mask:0xf bank_mask:0xf
    v_and_b32_dpp v87, v16, v27 row_newbcast:5 row_mask:0xf bank_mask:0xf
    v_and_b32_dpp v88, v16, v24 row_newbcast:6 row_mask:0xf bank_mask:0xf
    v_and_b32_dpp v89, v16, v25 row_newbcast:6 row_mask:0xf bank_mask:0xf
    v_and_b32_dpp v90, v16, v26 row_newbcast:6 row_mask:0xf bank_mask:0xf
    v_and_b32_dpp v91, v16, v27 row_newbcast:6 row_mask:0xf bank_mask:0xf
    v_and_b32_dpp v92, v16, v24 row_newbcast:7 row_mask:0xf bank_mask:0xf
    v_and_b32_dpp v93, v16, v25 row_newbcast:7 row_mask:0xf bank_mask:0xf
    v_and_b32_dpp v94, v16, v26 row_newbcast:7 row_mask:0xf bank_mask:0xf
    v_and_b32_dpp v95, v16, v27 row_newbcast:7 row_mask:0xf bank_mask:0xf
    s_lshr_b32 s44, s29, 1
    s_lshl4_add_u32 s45, s44, s30
    v_and_b32 v4, 7, v0
    v_lshlrev_b32 v7, 4, v4
    v_mov_b32 v9, 0xffff
    v_and_b32 v8, 4, v0
    v_cmp_eq_u32 vcc, 0, v8
    s_nop 1
    v_cndmask_b32 v24, 0, v9, vcc
    v_cndmask_b32 v25, v9, 0, vcc
    v_and_b32 v8, 3, v0
    v_xor_b32 v9, 1, v8
    v_lshl_or_b32 v8, v9, 2, v8
    v_mul_u32_u24 v26, 0x1111, v8
    s_lshl3_add_u32 s46, s30, s31
    s_lshl_b32 s56, s46, 16
    s_lshl_b32 s47, s29, 8
    s_add_u32 s56, s56, s47
    s_lshl_b32 s46, s46, 12
    s_add_u32 s46, s46, 2097152
    v_lshl_add_u32 v105, v6, 4, s46
    v_add_u32 v110, -786432, v103
    s_lshl_b32 s46, s29, 11
    s_add_u32 s46, s46, 32768
    v_min_u32 v8, 15, v2
    v_lshl_add_u32 v115, v8, 7, s46
    s_lshl4_add_u32 s46, s29, s30
    s_lshl_b32 s46, s46, 3
    s_add_u32 s46, s46, 3211264
    v_lshl_add_u32 v104, v6, 12, s46
    v_cmp_gt_u32 vcc, 16, v6
    s_nop 1
    v_cndmask_b32 v104, v127, v104, vcc
    s_lshl_b32 s46, s29, 12
    s_add_u32 s46, s46, 3145728
    v_lshl_add_u32 v106, v6, 5, s46
    s_lshl_b32 s46, s29, 9
    s_add_u32 s46, s46, 16384
    v_lshl_add_u32 v114, v6, 3, s46
    v_lshlrev_b32 v8, 4, v2
    v_lshl_add_u32 v111, v5, 13, v8
    v_bfe_u32 v8, v0, 5, 1
    v_lshl_add_u32 v111, v8, 11, v111
    s_mul_i32 s57, s30, 458752
    s_lshl_b32 s46, s31, 16
    s_add_u32 s57, s57, s46
    s_lshl_b32 s46, s29, 8
    s_add_u32 s57, s57, s46
    v_lshrrev_b32 v8, 3, v6
    v_lshl_add_u32 v8, v8, 14, v7
    s_mul_i32 s46, s30, 896
    s_lshl_b32 s47, s31, 7
    s_add_u32 s46, s46, s47
    s_add_u32 s46, s46, 1310720
    v_add_u32 v112, s46, v8
    s_waitcnt lgkmcnt(0)
    s_add_u32 s28, s28, 0x9e3779b1
    v_mov_b32 v123, s28
    v_mov_b32 v119, s28
    v_readlane_b32 s62, v107, 63
    s_lshl_b32 s45, s29, 8
    s_add_u32 s45, s45, 4096
    s_add_u32 s46, s45, 128
    s_waitcnt vmcnt(7)
    v_mfma_f32_16x16x32_bf16 v[96:99], v[64:67], v[32:35], 0
    s_waitcnt vmcnt(6)
    v_mfma_f32_16x16x32_bf16 v[96:99], v[68:71], v[36:39], v[96:99]
    s_waitcnt vmcnt(5)
    v_mfma_f32_16x16x32_bf16 v[96:99], v[72:75], v[40:43], v[96:99]
    s_waitcnt vmcnt(4)
    v_mfma_f32_16x16x32_bf16 v[96:99], v[76:79], v[44:47], v[96:99]
    s_waitcnt vmcnt(3)
    v_mfma_f32_16x16x32_bf16 v[96:99], v[80:83], v[48:51], v[96:99]
    s_waitcnt vmcnt(2)
    v_mfma_f32_16x16x32_bf16 v[96:99], v[84:87], v[52:55], v[96:99]
    s_waitcnt vmcnt(1)
    v_mfma_f32_16x16x32_bf16 v[96:99], v[88:91], v[56:59], v[96:99]
    s_waitcnt vmcnt(0)
    v_mfma_f32_16x16x32_bf16 v[96:99], v[92:95], v[60:63], v[96:99]
    s_nop 7
    ds_write_b128 v101, v[96:99] offset:0
    s_waitcnt lgkmcnt(0)
    s_barrier
    s_cmp_lg_u32 s31, 0
    s_cbranch_scc1 L_s1x
    ds_read_b128 v[64:67], v100 offset:0
    ds_read_b128 v[68:71], v100 offset:512
    ds_read_b128 v[72:75], v100 offset:1024
    ds_read_b128 v[76:79], v100 offset:1536
    ds_read_b128 v[80:83], v100 offset:2048
    ds_read_b128 v[84:87], v100 offset:2560
    ds_read_b128 v[88:91], v100 offset:3072
    ds_read_b128 v[92:95], v100 offset:3584
    s_waitcnt lgkmcnt(6)
    v_pk_add_f32 v[64:65], v[64:65], v[68:69]
    v_pk_add_f32 v[66:67], v[66:67], v[70:71]
    s_waitcnt lgkmcnt(4)
    v_pk_add_f32 v[72:73], v[72:73], v[76:77]
    v_pk_add_f32 v[74:75], v[74:75], v[78:79]
    s_waitcnt lgkmcnt(2)
    v_pk_add_f32 v[80:81], v[80:81], v[84:85]
    v_pk_add_f32 v[82:83], v[82:83], v[86:87]
    s_waitcnt lgkmcnt(0)
    v_pk_add_f32 v[88:89], v[88:89], v[92:93]
    v_pk_add_f32 v[90:91], v[90:91], v[94:95]
    v_pk_add_f32 v[64:65], v[64:65], v[72:73]
    v_pk_add_f32 v[66:67], v[66:67], v[74:75]
    v_pk_add_f32 v[80:81], v[80:81], v[88:89]
    v_pk_add_f32 v[82:83], v[82:83], v[90:91]
    v_pk_add_f32 v[64:65], v[64:65], v[80:81]
    v_pk_add_f32 v[66:67], v[66:67], v[82:83]
    v_perm_b32 v120, v64, v67, s33
    v_perm_b32 v121, v65, v67, s34
    v_perm_b32 v122, v66, v67, s35
    buffer_store_dwordx4 v[120:123], v102, s[4:7], 0 offen sc1
L_s1x:
    s_barrier
    s_getreg_b32 s44, hwreg(HW_REG_XCC_ID, 0, 4)
    buffer_load_dwordx4 v[32:35], v111, s[12:15], s56 offen nt
    s_add_u32 s56, s56, 4096
    buffer_load_dwordx4 v[36:39], v111, s[12:15], s56 offen nt
    s_add_u32 s56, s56, 12288
    v_mov_b32 v96, 0
    v_mov_b32 v97, 0
    v_mov_b32 v98, 0
    v_mov_b32 v99, 0
    s_waitcnt vmcnt(0)
    buffer_load_dwordx4 v[40:43], v111, s[12:15], s56 offen nt
    s_add_u32 s56, s56, 4096
    buffer_load_dwordx4 v[44:47], v111, s[12:15], s56 offen nt
    s_add_u32 s56, s56, 12288
    buffer_load_dwordx4 v[48:51], v111, s[12:15], s56 offen nt
    s_add_u32 s56, s56, 4096
    buffer_load_dwordx4 v[52:55], v111, s[12:15], s56 offen nt
    s_add_u32 s56, s56, 12288
    buffer_load_dwordx4 v[56:59], v111, s[12:15], s56 offen nt
    s_add_u32 s56, s56, 4096
    buffer_load_dwordx4 v[60:63], v111, s[12:15], s56 offen nt
    s_waitcnt vmcnt(1)
    s_movk_i32 s52, 100
L_bb:
    buffer_load_dwordx2 v[8:9], v114, s[4:7], 0 offen sc1
    s_waitcnt vmcnt(0)
    v_cmp_ne_u32 vcc, s28, v8
    v_cmp_ne_u32 s[50:51], s28, v9
    s_or_b64 vcc, vcc, s[50:51]
    s_cbranch_scc1 L_bb_r
L_bb_x:
    s_cmp_lg_u32 s31, 0
    s_cbranch_scc1 L_noid
    buffer_load_dwordx2 v[116:117], v115, s[4:7], 0 offen sc1
L_noid:
    buffer_load_dwordx4 v[8:11], v105, s[4:7], 0 offen offset:0 sc1
    buffer_load_dwordx4 v[12:15], v105, s[4:7], 0 offen offset:1024 sc1
    buffer_load_dwordx4 v[16:19], v105, s[4:7], 0 offen offset:2048 sc1
    buffer_load_dwordx4 v[20:23], v105, s[4:7], 0 offen offset:3072 sc1
    s_mov_b32 s58, 0x80000
L_gb_w:
    s_waitcnt vmcnt(0)
    v_cmp_ne_u32 s[48:49], s28, v11
    v_cmp_ne_u32 s[50:51], s28, v15
    v_cmp_ne_u32 s[52:53], s28, v19
    v_cmp_ne_u32 s[54:55], s28, v23
    s_or_b64 vcc, s[48:49], s[50:51]
    s_or_b64 vcc, vcc, s[52:53]
    s_or_b64 vcc, vcc, s[54:55]
    s_cbranch_scc1 L_gb_r
    v_max3_f32 v64, v10, v14, v18
    v_max_f32 v64, v64, v22
    v_lshlrev_b32 v66, 16, v8
    v_and_b32 v67, 0xffff0000, v8
    v_lshlrev_b32 v68, 16, v9
    v_and_b32 v69, 0xffff0000, v9
    v_max_f32_dpp v64, v64, v64 row_ror:8 row_mask:0xf bank_mask:0xf
    v_mov_b32 v65, v64
    v_lshlrev_b32 v70, 16, v12
    v_and_b32 v71, 0xffff0000, v12
    v_lshlrev_b32 v72, 16, v13
    v_and_b32 v73, 0xffff0000, v13
    v_permlane16_swap_b32 v64, v65
    v_max_f32 v64, v64, v65
    v_mov_b32 v65, v64
    v_lshlrev_b32 v74, 16, v16
    v_and_b32 v75, 0xffff0000, v16
    v_lshlrev_b32 v76, 16, v17
    v_and_b32 v77, 0xffff0000, v17
    v_permlane32_swap_b32 v64, v65
    v_max_f32 v64, v64, v65
    v_sub_f32 v82, v10, v64
    v_sub_f32 v83, v14, v64
    v_sub_f32 v84, v18, v64
    v_sub_f32 v85, v22, v64
    v_exp_f32 v82, v82
    v_exp_f32 v83, v83
    v_exp_f32 v84, v84
    v_exp_f32 v85, v85
    v_lshlrev_b32 v78, 16, v20
    v_and_b32 v79, 0xffff0000, v20
    v_lshlrev_b32 v80, 16, v21
    v_and_b32 v81, 0xffff0000, v21
    v_pk_add_f32 v[86:87], v[82:83], v[84:85]
    v_pk_mul_f32 v[8:9], v[66:67], v[82:83] op_sel_hi:[1,0]
    v_pk_mul_f32 v[10:11], v[68:69], v[82:83] op_sel_hi:[1,0]
    v_add_f32 v86, v86, v87
    v_pk_fma_f32 v[8:9], v[70:71], v[82:83], v[8:9] op_sel:[0,1,0] op_sel_hi:[1,1,1]
    v_pk_fma_f32 v[10:11], v[72:73], v[82:83], v[10:11] op_sel:[0,1,0] op_sel_hi:[1,1,1]
    v_add_f32_dpp v86, v86, v86 row_ror:8 row_mask:0xf bank_mask:0xf
    v_pk_fma_f32 v[8:9], v[74:75], v[84:85], v[8:9] op_sel_hi:[1,0,1]
    v_pk_fma_f32 v[10:11], v[76:77], v[84:85], v[10:11] op_sel_hi:[1,0,1]
    v_mov_b32 v87, v86
    v_pk_fma_f32 v[8:9], v[78:79], v[84:85], v[8:9] op_sel:[0,1,0] op_sel_hi:[1,1,1]
    v_pk_fma_f32 v[10:11], v[80:81], v[84:85], v[10:11] op_sel:[0,1,0] op_sel_hi:[1,1,1]
    v_permlane16_swap_b32 v86, v87
    s_nop 0
    v_permlane32_swap_b32 v8, v10
    v_add_f32 v86, v86, v87
    v_permlane32_swap_b32 v9, v11
    v_mov_b32 v87, v86
    v_pk_add_f32 v[8:9], v[8:9], v[10:11]
    s_nop 0
    v_permlane32_swap_b32 v86, v87
    v_permlane16_swap_b32 v8, v9
    v_add_f32 v86, v86, v87
    v_add_f32 v8, v8, v9
    v_rcp_f32 v86, v86
    s_nop 0
    v_add_f32_dpp v8, v8, v8 row_ror:8 row_mask:0xf bank_mask:0xf
    v_mul_f32 v8, v8, v86
    v_cvt_pk_bf16_f32 v8, v8, v8
    s_nop 1
    v_and_b32_dpp v12, v8, v24 row_newbcast:0 row_mask:0xf bank_mask:0xf
    v_and_b32_dpp v13, v8, v25 row_newbcast:0 row_mask:0xf bank_mask:0xf
    v_and_b32_dpp v14, v8, v24 row_newbcast:1 row_mask:0xf bank_mask:0xf
    v_and_b32_dpp v15, v8, v25 row_newbcast:1 row_mask:0xf bank_mask:0xf
    v_and_b32_dpp v16, v8, v24 row_newbcast:2 row_mask:0xf bank_mask:0xf
    v_and_b32_dpp v17, v8, v25 row_newbcast:2 row_mask:0xf bank_mask:0xf
    v_and_b32_dpp v18, v8, v24 row_newbcast:3 row_mask:0xf bank_mask:0xf
    v_and_b32_dpp v19, v8, v25 row_newbcast:3 row_mask:0xf bank_mask:0xf
    v_smfmac_f32_16x16x64_bf16 v[96:99], v[12:15], v[32:39], v26
    v_and_b32_dpp v12, v8, v24 row_newbcast:4 row_mask:0xf bank_mask:0xf
    v_and_b32_dpp v13, v8, v25 row_newbcast:4 row_mask:0xf bank_mask:0xf
    v_and_b32_dpp v14, v8, v24 row_newbcast:5 row_mask:0xf bank_mask:0xf
    v_and_b32_dpp v15, v8, v25 row_newbcast:5 row_mask:0xf bank_mask:0xf
    v_smfmac_f32_16x16x64_bf16 v[96:99], v[16:19], v[40:47], v26
    v_and_b32_dpp v16, v8, v24 row_newbcast:6 row_mask:0xf bank_mask:0xf
    v_and_b32_dpp v17, v8, v25 row_newbcast:6 row_mask:0xf bank_mask:0xf
    v_and_b32_dpp v18, v8, v24 row_newbcast:7 row_mask:0xf bank_mask:0xf
    v_and_b32_dpp v19, v8, v25 row_newbcast:7 row_mask:0xf bank_mask:0xf
    v_smfmac_f32_16x16x64_bf16 v[96:99], v[12:15], v[48:55], v26
    s_nop 0
    v_smfmac_f32_16x16x64_bf16 v[96:99], v[16:19], v[56:63], v26
    s_nop 7
    ds_write_b128 v101, v[96:99] offset:4096
    s_waitcnt lgkmcnt(0)
    s_barrier
    v_mov_b32 v96, 0
    v_mov_b32 v97, 0
    v_mov_b32 v98, 0
    v_mov_b32 v99, 0
    s_cmp_lg_u32 s31, 0
    s_cbranch_scc1 L_s3x
    v_cmp_ne_u32 vcc, s28, v117
    v_cmp_ne_u32 s[50:51], s44, v116
    s_or_b64 vcc, vcc, s[50:51]
    s_cselect_b32 s39, 0, 1
    ds_read_b128 v[64:67], v100 offset:4096
    ds_read_b128 v[68:71], v100 offset:4608
    ds_read_b128 v[72:75], v100 offset:5120
    ds_read_b128 v[76:79], v100 offset:5632
    ds_read_b128 v[80:83], v100 offset:6144
    ds_read_b128 v[84:87], v100 offset:6656
    ds_read_b128 v[88:91], v100 offset:7168
    ds_read_b128 v[92:95], v100 offset:7680
    s_waitcnt lgkmcnt(6)
    v_pk_add_f32 v[64:65], v[64:65], v[68:69]
    v_pk_add_f32 v[66:67], v[66:67], v[70:71]
    s_waitcnt lgkmcnt(4)
    v_pk_add_f32 v[72:73], v[72:73], v[76:77]
    v_pk_add_f32 v[74:75], v[74:75], v[78:79]
    s_waitcnt lgkmcnt(2)
    v_pk_add_f32 v[80:81], v[80:81], v[84:85]
    v_pk_add_f32 v[82:83], v[82:83], v[86:87]
    s_waitcnt lgkmcnt(0)
    v_pk_add_f32 v[88:89], v[88:89], v[92:93]
    v_pk_add_f32 v[90:91], v[90:91], v[94:95]
    v_pk_add_f32 v[64:65], v[64:65], v[72:73]
    v_pk_add_f32 v[66:67], v[66:67], v[74:75]
    v_pk_add_f32 v[80:81], v[80:81], v[88:89]
    v_pk_add_f32 v[82:83], v[82:83], v[90:91]
    v_pk_add_f32 v[64:65], v[64:65], v[80:81]
    v_pk_add_f32 v[66:67], v[66:67], v[82:83]
    v_perm_b32 v120, v64, v67, s33
    v_perm_b32 v121, v65, v67, s34
    v_perm_b32 v122, v66, v67, s35
    s_cmp_eq_u32 s39, 0
    s_cbranch_scc1 L_c1_far
    buffer_store_dwordx4 v[120:123], v110, s[4:7], 0 offen
L_c1_done:
    v_pk_add_f32 v[64:65], v[64:65], v[66:67]
    v_add_f32 v64, v64, v65
    s_nop 1
    v_add_f32_dpp v64, v64, v64 quad_perm:[1,0,3,2] row_mask:0xf bank_mask:0xf
    s_nop 1
    v_add_f32_dpp v64, v64, v64 quad_perm:[2,3,0,1] row_mask:0xf bank_mask:0xf
    s_nop 1
    v_add_f32_dpp v64, v64, v64 row_half_mirror row_mask:0xf bank_mask:0xf
    s_nop 1
    v_add_f32_dpp v64, v64, v64 row_mirror row_mask:0xf bank_mask:0xf
    v_mov_b32 v65, v64
    s_nop 1
    v_permlane16_swap_b32 v64, v65
    v_add_f32 v64, v64, v65
    v_add_f32 v118, s62, v64
    buffer_store_dwordx2 v[118:119], v104, s[4:7], 0 offen sc1
L_s3x:
    s_barrier
    s_cmp_eq_u32 s31, 7
    s_cbranch_scc1 L_end
    buffer_load_dwordx4 v[32:35], v111, s[20:23], s57 offen nt
    s_add_u32 s57, s57, 4096
    buffer_load_dwordx4 v[36:39], v111, s[20:23], s57 offen nt
    s_add_u32 s57, s57, 12288
    buffer_load_dwordx4 v[40:43], v111, s[20:23], s57 offen nt
    s_add_u32 s57, s57, 4096
    buffer_load_dwordx4 v[44:47], v111, s[20:23], s57 offen nt
    s_add_u32 s57, s57, 12288
    s_waitcnt vmcnt(0)
    buffer_load_dwordx4 v[48:51], v111, s[20:23], s57 offen nt
    s_add_u32 s57, s57, 4096
    buffer_load_dwordx4 v[52:55], v111, s[20:23], s57 offen nt
    s_add_u32 s57, s57, 12288
    buffer_load_dwordx4 v[56:59], v111, s[20:23], s57 offen nt
    s_add_u32 s57, s57, 4096
    buffer_load_dwordx4 v[60:63], v111, s[20:23], s57 offen nt
    s_lshl_b32 s45, s29, 7
    s_add_u32 s45, s45, 12288
    v_min_u32 v114, 15, v2
    v_lshl_add_u32 v114, v114, 2, s45
    s_mov_b32 s53, 0
    s_mov_b32 s55, 0
    s_mov_b32 s54, 131072
    s_waitcnt vmcnt(1)
    s_movk_i32 s52, 100
L_bd:
    buffer_load_dword v8, v114, s[4:7], 0 offen sc1
    s_waitcnt vmcnt(0)
    v_cmp_ne_u32 vcc, s28, v8
    s_cbranch_vccnz L_bd_r
L_bd_x:
    buffer_load_dwordx4 v[20:23], v106, s[4:7], s55 offen sc1
    buffer_load_dwordx4 v[8:11], v112, s[4:7], s53 offen sc1
    buffer_load_dwordx4 v[12:15], v112, s[4:7], s54 offen sc1
    s_waitcnt vmcnt(2)
L_ps_c:
    v_cmp_ne_u32 vcc, s28, v23
    s_cbranch_vccnz L_ps_r
    v_permlane32_swap_b32 v20, v21
    v_add_f32 v20, v20, v21
    s_nop 1
    v_add_f32_dpp v20, v20, v20 quad_perm:[1,0,3,2] row_mask:0xf bank_mask:0xf
    s_nop 1
    v_add_f32_dpp v20, v20, v20 quad_perm:[2,3,0,1] row_mask:0xf bank_mask:0xf
    s_nop 1
    v_add_f32_dpp v20, v20, v20 row_half_mirror row_mask:0xf bank_mask:0xf
    s_nop 1
    v_add_f32_dpp v20, v20, v20 row_mirror row_mask:0xf bank_mask:0xf
    v_mov_b32 v21, v20
    s_nop 1
    v_permlane16_swap_b32 v20, v21
    v_add_f32 v20, v20, v21
    v_mul_f32 v20, 0x3a800000, v20
    v_mov_b32 v21, v20
    s_nop 1
    v_permlane32_swap_b32 v20, v21
    v_fma_f32 v21, -v20, v20, v21
    v_max_f32 v21, 0, v21
    v_cvt_pk_bf16_f32 v21, 0, v21
    v_add_f32 v21, 0x3727c5ac, v21
    v_cvt_pk_bf16_f32 v21, 0, v21
    v_sqrt_f32 v21, v21
    s_nop 0
    v_cvt_pk_bf16_f32 v21, 0, v21
    v_rcp_f32 v22, v21
L_gd_w:
    s_waitcnt vmcnt(0)
    v_cmp_ne_u32 vcc, s28, v11
    v_cmp_ne_u32 s[50:51], s28, v15
    s_or_b64 vcc, vcc, s[50:51]
    s_cbranch_scc1 L_gd_r
    v_perm_b32 v16, v9, v8, s36
    v_perm_b32 v11, v10, v16, s37
    v_perm_b32 v17, v13, v12, s36
    v_perm_b32 v15, v14, v17, s37
    v_pk_add_f32 v[8:9], v[8:9], v[12:13]
    v_pk_add_f32 v[10:11], v[10:11], v[14:15]
    s_nop 0
    v_permlane16_swap_b32 v8, v9
    v_permlane16_swap_b32 v10, v11
    v_add_f32 v8, v8, v9
    v_add_f32 v10, v10, v11
    s_nop 0
    v_add_f32_dpp v8, v8, v8 row_ror:8 row_mask:0xf bank_mask:0xf
    v_add_f32_dpp v10, v10, v10 row_ror:8 row_mask:0xf bank_mask:0xf
    s_nop 1
    v_permlane32_swap_b32 v8, v10
    v_mul_f32 v8, v8, v22
    v_mul_f32 v10, v10, v22
    v_cvt_pk_bf16_f32 v8, 0, v8
    v_cvt_pk_bf16_f32 v10, 0, v10
    v_mul_f32 v9, v8, v8
    v_mov_b32 v11, 0xc0135761
    v_fmamk_f32 v9, v9, 0xbdd2d3e8, v11
    v_mul_f32 v9, v9, v8
    v_exp_f32 v9, v9
    s_nop 0
    v_add_f32 v9, 1.0, v9
    v_rcp_f32 v9, v9
    s_nop 0
    v_mul_f32 v8, v8, v9
    v_cvt_pk_bf16_f32 v8, 0, v8
    v_mul_f32 v8, v8, v10
    v_cvt_pk_bf16_f32 v8, v8, v8
    s_nop 1
    v_and_b32_dpp v12, v8, v24 row_newbcast:0 row_mask:0xf bank_mask:0xf
    v_and_b32_dpp v13, v8, v25 row_newbcast:0 row_mask:0xf bank_mask:0xf
    v_and_b32_dpp v14, v8, v24 row_newbcast:1 row_mask:0xf bank_mask:0xf
    v_and_b32_dpp v15, v8, v25 row_newbcast:1 row_mask:0xf bank_mask:0xf
    v_and_b32_dpp v16, v8, v24 row_newbcast:2 row_mask:0xf bank_mask:0xf
    v_and_b32_dpp v17, v8, v25 row_newbcast:2 row_mask:0xf bank_mask:0xf
    v_and_b32_dpp v18, v8, v24 row_newbcast:3 row_mask:0xf bank_mask:0xf
    v_and_b32_dpp v19, v8, v25 row_newbcast:3 row_mask:0xf bank_mask:0xf
    v_smfmac_f32_16x16x64_bf16 v[96:99], v[12:15], v[32:39], v26
    v_and_b32_dpp v12, v8, v24 row_newbcast:4 row_mask:0xf bank_mask:0xf
    v_and_b32_dpp v13, v8, v25 row_newbcast:4 row_mask:0xf bank_mask:0xf
    v_and_b32_dpp v14, v8, v24 row_newbcast:5 row_mask:0xf bank_mask:0xf
    v_and_b32_dpp v15, v8, v25 row_newbcast:5 row_mask:0xf bank_mask:0xf
    v_smfmac_f32_16x16x64_bf16 v[96:99], v[16:19], v[40:47], v26
    v_and_b32_dpp v16, v8, v24 row_newbcast:6 row_mask:0xf bank_mask:0xf
    v_and_b32_dpp v17, v8, v25 row_newbcast:6 row_mask:0xf bank_mask:0xf
    v_and_b32_dpp v18, v8, v24 row_newbcast:7 row_mask:0xf bank_mask:0xf
    v_and_b32_dpp v19, v8, v25 row_newbcast:7 row_mask:0xf bank_mask:0xf
    v_smfmac_f32_16x16x64_bf16 v[96:99], v[12:15], v[48:55], v26
    s_nop 0
    v_smfmac_f32_16x16x64_bf16 v[96:99], v[16:19], v[56:63], v26
    s_nop 7
    ds_write_b128 v101, v[96:99] offset:8192
    s_waitcnt lgkmcnt(0)
    s_barrier
    s_cmp_lg_u32 s31, 0
    s_cbranch_scc1 L_end
    ds_read_b128 v[64:67], v100 offset:8192
    ds_read_b128 v[68:71], v100 offset:8704
    ds_read_b128 v[72:75], v100 offset:9216
    ds_read_b128 v[76:79], v100 offset:9728
    ds_read_b128 v[80:83], v100 offset:10240
    ds_read_b128 v[84:87], v100 offset:10752
    ds_read_b128 v[88:91], v100 offset:11264
    s_waitcnt lgkmcnt(5)
    v_pk_add_f32 v[64:65], v[64:65], v[68:69]
    v_pk_add_f32 v[66:67], v[66:67], v[70:71]
    s_waitcnt lgkmcnt(3)
    v_pk_add_f32 v[72:73], v[72:73], v[76:77]
    v_pk_add_f32 v[74:75], v[74:75], v[78:79]
    s_waitcnt lgkmcnt(1)
    v_pk_add_f32 v[80:81], v[80:81], v[84:85]
    v_pk_add_f32 v[82:83], v[82:83], v[86:87]
    s_waitcnt lgkmcnt(0)
    v_pk_add_f32 v[64:65], v[64:65], v[72:73]
    v_pk_add_f32 v[66:67], v[66:67], v[74:75]
    v_pk_add_f32 v[80:81], v[80:81], v[88:89]
    v_pk_add_f32 v[82:83], v[82:83], v[90:91]
    v_pk_add_f32 v[64:65], v[64:65], v[80:81]
    v_pk_add_f32 v[66:67], v[66:67], v[82:83]
    v_perm_b32 v120, v64, v67, s33
    v_perm_b32 v121, v65, v67, s34
    v_perm_b32 v122, v66, v67, s35
    s_cmp_eq_u32 s39, 0
    s_cbranch_scc1 L_e_far
    buffer_store_dwordx4 v[120:123], v103, s[4:7], 0 offen
L_e_done:
    s_endpgm
L_gq_r:
    s_mov_b32 s56, 65536
    s_sub_u32 s32, s32, 1
    s_cbranch_scc0 L_gq
    s_endpgm
L_gc_r:
    s_sub_u32 s32, s32, 1
    s_cbranch_scc0 L_gc
    s_endpgm
L_gc:
    buffer_load_dwordx4 v[8:11], v103, s[4:7], 0 offen sc1
    s_branch L_gc_w
L_hst:
    s_cmp_lt_u32 s57, 4
    s_cbranch_scc1 L_hst_x
    v_mul_f32 v117, v100, v100
    v_mov_b32 v116, v100
    s_nop 1
    v_permlane32_swap_b32 v116, v117
    v_add_f32 v116, v116, v117
    s_nop 1
    v_add_f32_dpp v116, v116, v116 quad_perm:[1,0,3,2] row_mask:0xf bank_mask:0xf
    s_nop 1
    v_add_f32_dpp v116, v116, v116 quad_perm:[2,3,0,1] row_mask:0xf bank_mask:0xf
    v_mov_b32 v117, v116
    s_nop 1
    v_permlane16_swap_b32 v116, v117
    v_add_f32 v116, v116, v117
    v_mov_b32 v117, v116
    s_nop 1
    v_permlane32_swap_b32 v116, v117
    buffer_store_dwordx4 v[116:119], v125, s[4:7], 0 offen sc1
    s_branch L_hst_x
L_q4:
    s_cmp_lt_u32 s30, 14
    s_cbranch_scc1 L_end
    s_cmp_lg_u32 s2, 248
    s_cbranch_scc1 L_g3
    v_mov_b32 v4, 0
    v_cmp_eq_u32 vcc, 0, v0
    s_nop 1
    v_cndmask_b32 v4, v127, v4, vcc
    buffer_store_dword v123, v4, s[4:7], 0 offen sc1
    s_branch L_g3
L_gs_r:
    s_mov_b32 s56, 0x8000
    s_sub_u32 s32, s32, 1
    s_cbranch_scc0 L_gs
    s_endpgm
L_gs:
    buffer_load_dwordx4 v[20:23], v108, s[4:7], s56 offen sc1
    s_waitcnt vmcnt(0)
    s_branch L_gs_c
L_g3_r:
    s_sub_u32 s32, s32, 1
    s_cbranch_scc0 L_g3
    s_endpgm
L_bb_r:
    s_sub_u32 s52, s52, 1
    s_cbranch_scc0 L_bb
    s_branch L_bb_x
L_gb_r:
    s_sub_u32 s32, s32, 1
    s_cbranch_scc0 L_gb
    s_endpgm
L_gb:
    s_mov_b64 exec, s[48:49]
    buffer_load_dwordx4 v[8:11], v105, s[4:7], s58 offen offset:0 sc1
    s_mov_b64 exec, s[50:51]
    buffer_load_dwordx4 v[12:15], v105, s[4:7], s58 offen offset:1024 sc1
    s_mov_b64 exec, s[52:53]
    buffer_load_dwordx4 v[16:19], v105, s[4:7], s58 offen offset:2048 sc1
    s_mov_b64 exec, s[54:55]
    buffer_load_dwordx4 v[20:23], v105, s[4:7], s58 offen offset:3072 sc1
    s_mov_b64 exec, -1
    s_branch L_gb_w
L_c1_far:
    buffer_store_dwordx4 v[120:123], v110, s[4:7], 0 offen sc1
    s_branch L_c1_done
L_bd_r:
    s_sub_u32 s52, s52, 1
    s_cbranch_scc0 L_bd
    s_branch L_bd_x
L_ps_r:
    s_mov_b32 s55, 0x8000
    s_sub_u32 s32, s32, 1
    s_cbranch_scc0 L_ps
    s_endpgm
L_ps:
    buffer_load_dwordx4 v[20:23], v106, s[4:7], s55 offen sc1
    s_waitcnt vmcnt(0)
    s_branch L_ps_c
L_gd:
    buffer_load_dwordx4 v[8:11], v112, s[4:7], s53 offen sc1
    buffer_load_dwordx4 v[12:15], v112, s[4:7], s54 offen sc1
    s_branch L_gd_w
L_gd_r:
    s_mov_b32 s53, 262144
    s_mov_b32 s54, 393216
    s_sub_u32 s32, s32, 1
    s_cbranch_scc0 L_gd
    s_endpgm
L_e_far:
    buffer_store_dwordx4 v[120:123], v103, s[4:7], 0 offen sc1
    s_branch L_e_done
L_end:
    s_endpgm
L_last:
.section .rodata,"a"
.p2align 6
.amdhsa_kernel sequential_preLN__sliding_block_cached__geglu_ffn__decode_kernel
  .amdhsa_next_free_vgpr 192
  .amdhsa_next_free_sgpr 102
  .amdhsa_accum_offset 192
  .amdhsa_group_segment_fixed_size 0
  .amdhsa_kernarg_size 96
  .amdhsa_user_sgpr_count 2
  .amdhsa_user_sgpr_kernarg_segment_ptr 1
  .amdhsa_system_sgpr_workgroup_id_x 1
  .amdhsa_float_denorm_mode_32 3
.end_amdhsa_kernel
```
